```python
import torch

def _softmax(x, axis=-1):
    return torch.softmax(x, dim=axis)

def _gelu(x):
    return torch.nn.functional.gelu(x, approximate='tanh')

def _silu(x):
    return torch.nn.functional.silu(x)

def _sigmoid(x):
    return torch.sigmoid(x)

def _layernorm(x, axis=-1, eps=1e-05):
    m = x.mean(dim=axis, keepdim=True)
    v = x.var(dim=axis, keepdim=True, unbiased=False)
    return (x - m) / torch.sqrt(v + eps)

def _scatter_add(tgt, idx, src, axis=0):
    return tgt.clone().index_add_(axis, idx, src)

def _segment_sum(src, seg, n):
    out = torch.zeros((n,) + src.shape[1:], dtype=src.dtype)
    return out.index_add_(0, seg, src)

def _pad(x, pw):
    flat = tuple((v for pair in reversed(pw) for v in pair))
    return torch.nn.functional.pad(x, flat)
kernel_name = 'standalone__tree_speculative_verify_tree_attention_over_candidate_token_tree__decode'

def setup_inputs():

    _w = lambda a: (lambda t: t.to(torch.bfloat16) if t.is_floating_point() else t)(torch.as_tensor(a))
    B, Hq, Hkv, T, C, D = (1, 32, 32, 1, 4096, 128)
    tree_mask = torch.zeros((B, T, T), dtype=float)
    for b in range(B):
        parent = torch.zeros(T, dtype=torch.int64)
        for i in range(1, T):
            parent[i] = int(torch.randint(0, i, (1,)).item())
        for i in range(T):
            j = i
            tree_mask[b, i, j] = 1.0
            while j > 0:
                j = parent[j]
                tree_mask[b, i, j] = 1.0
    return {'q': _w((lambda *s: torch.randn(*s, dtype=torch.bfloat16) * 0.8)(B, Hq, T, D)), 'k_cache': _w((lambda *s: torch.randn(*s, dtype=torch.bfloat16) * 0.8)(B, Hkv, C, D)), 'v_cache': _w((lambda *s: torch.randn(*s, dtype=torch.bfloat16) * 0.05)(B, Hkv, C, D)), 'k_tree': _w((lambda *s: torch.randn(*s, dtype=torch.bfloat16) * 0.8)(B, Hkv, T, D)), 'v_tree': _w((lambda *s: torch.randn(*s, dtype=torch.bfloat16) * 0.05)(B, Hkv, T, D)), 'tree_mask': _w(tree_mask)}

def reference(q, k_cache, v_cache, k_tree, v_tree, tree_mask):
    B, Hq, T, D = q.shape
    Hkv, C = (k_cache.shape[1], k_cache.shape[2])
    rep = Hq // Hkv
    kc = (lambda x, n, axis: torch.repeat_interleave(x, n, dim=axis))(k_cache, rep, axis=1)
    vc = (lambda x, n, axis: torch.repeat_interleave(x, n, dim=axis))(v_cache, rep, axis=1)
    kt = (lambda x, n, axis: torch.repeat_interleave(x, n, dim=axis))(k_tree, rep, axis=1)
    vt = (lambda x, n, axis: torch.repeat_interleave(x, n, dim=axis))(v_tree, rep, axis=1)
    k = torch.concatenate([kc, kt], axis=2)
    v = torch.concatenate([vc, vt], axis=2)
    scale = D ** (-0.5)
    scores = torch.einsum('bhqd,bhkd->bhqk', q, k) * scale
    ctx_mask = torch.ones((B, 1, T, C), dtype=scores.dtype)
    tm = tree_mask[:, None, :, :].clone()
    full_mask = torch.concatenate([ctx_mask, tm], axis=-1)
    scores = scores + (1.0 - full_mask) * -1000000000.0
    p = _softmax(scores, axis=-1)
    return torch.einsum('bhqk,bhkd->bhqd', p, v)
```

```asm
; @launch grid=(256,1,1) block=(576,1,1) lds=4096
.amdgcn_target "amdgcn-amd-amdhsa--gfx950"
.text
.globl standalone__tree_speculative_verify_tree_attention_over_candidate_token_tree__decode_kernel
.p2align 8
.type standalone__tree_speculative_verify_tree_attention_over_candidate_token_tree__decode_kernel,@function
standalone__tree_speculative_verify_tree_attention_over_candidate_token_tree__decode_kernel:
    s_load_dwordx2 s[24:25], s[0:1], 8
    s_load_dwordx2 s[32:33], s[0:1], 0
    s_load_dwordx2 s[28:29], s[0:1], 16
    v_lshrrev_b32 v1, 6, v0
    s_cmp_ge_u32 s2, 256
    s_cbranch_scc1 L_end
    v_readfirstlane_b32 s3, v1
    v_and_b32 v0, 63, v0
    s_and_b32 s22, s2, 7
    s_lshl_b32 s22, s22, 5
    s_lshr_b32 s23, s2, 3
    s_or_b32 s21, s22, s23
    s_mov_b32 s26, 0x2000000
    s_mov_b32 s27, 0x20000
    s_mov_b32 s34, 8192
    s_mov_b32 s35, 0x20000
    s_lshr_b32 s22, s21, 3
    s_cmp_eq_u32 s3, 8
    s_cbranch_scc1 L_helper
    s_lshl_b32 s4, s21, 17
    s_lshl_b32 s5, s3, 10
    s_add_u32 s4, s4, s5
    v_lshl_add_u32 v1, v0, 4, s4
    v_and_b32 v2, 15, v0
    s_lshl_b32 s5, s22, 8
    v_lshl_add_u32 v2, v2, 4, s5
    s_movk_i32 s7, 0x2000
    s_movk_i32 s6, 0x4000
    s_waitcnt lgkmcnt(0)
    buffer_load_dwordx4 v[36:39], v1, s[24:27], 0 offen nt
    buffer_load_dwordx4 v[4:7], v2, s[32:35], 0 offen
    buffer_load_dwordx4 v[40:43], v1, s[24:27], s7 offen nt
    buffer_load_dwordx4 v[44:47], v1, s[24:27], s6 offen nt
    s_bitcmp1_b32 s2, 0
    s_cbranch_scc1 L_k1
    s_load_dwordx2 s[40:41], s[0:1], 64
    s_mov_b32 s30, 0x2000000
    s_mov_b32 s31, 0x20000
    v_and_b32 v3, 1, v0
    v_mov_b32 v2, 0xffff
    v_lshlrev_b32 v3, 4, v3
    v_lshlrev_b32 v2, v3, v2
    v_bfe_u32 v3, v0, 1, 3
    v_cmp_eq_u32 s[8:9], 0, v3
    v_cmp_eq_u32 s[10:11], 2, v3
    v_cmp_eq_u32 s[12:13], 4, v3
    v_cmp_eq_u32 s[14:15], 6, v3
    s_lshl_b32 s4, s3, 9
    s_add_u32 s4, s4, 512
    s_lshl_b32 s5, s3, 3
    s_mov_b32 s42, 0x100000
    s_mov_b32 s43, 0x20000
    v_cndmask_b32 v8, 0, v2, s[8:9]
    v_cndmask_b32 v9, 0, v2, s[10:11]
    v_cndmask_b32 v10, 0, v2, s[12:13]
    v_cndmask_b32 v11, 0, v2, s[14:15]
    v_lshl_add_u32 v2, v0, 3, s4
    v_mov_b32 v3, s5
    s_mov_b32 s8, 0xcccccccc
    s_mov_b32 s9, 0xcccccccc
    s_mov_b32 s10, 0xaaaaaaaa
    s_mov_b32 s11, 0xaaaaaaaa
    s_mov_b32 s12, 0x3e0293ee
    s_barrier
    s_movk_i32 s7, 0x6000
    s_waitcnt vmcnt(2)
    buffer_load_dwordx4 v[48:51], v1, s[24:27], s7 offen nt
    s_addk_i32 s7, 0x2000
    s_waitcnt vmcnt(2)
    buffer_load_dwordx4 v[52:55], v1, s[24:27], s7 offen nt
    s_addk_i32 s7, 0x2000
    s_waitcnt vmcnt(2)
    buffer_load_dwordx4 v[56:59], v1, s[24:27], s7 offen nt
    s_addk_i32 s7, 0x2000
    s_waitcnt vmcnt(2)
    buffer_load_dwordx4 v[60:63], v1, s[24:27], s7 offen nt
    v_dot2_f32_bf16 v20, v36, v4, 0
    v_dot2_f32_bf16 v21, v40, v4, 0
    v_dot2_f32_bf16 v22, v44, v4, 0
    v_dot2_f32_bf16 v23, v48, v4, 0
    v_dot2c_f32_bf16 v20, v37, v5
    v_dot2c_f32_bf16 v21, v41, v5
    v_dot2c_f32_bf16 v22, v45, v5
    v_dot2c_f32_bf16 v23, v49, v5
    v_dot2c_f32_bf16 v20, v38, v6
    v_dot2c_f32_bf16 v21, v42, v6
    v_dot2c_f32_bf16 v22, v46, v6
    v_dot2c_f32_bf16 v23, v50, v6
    v_dot2c_f32_bf16 v20, v39, v7
    v_dot2c_f32_bf16 v21, v43, v7
    v_dot2c_f32_bf16 v22, v47, v7
    v_dot2c_f32_bf16 v23, v51, v7
    v_add_f32_dpp v20, v20, v20 row_ror:8 row_mask:0xf bank_mask:0x3
    v_add_f32_dpp v20, v21, v21 row_ror:8 row_mask:0xf bank_mask:0xc
    v_add_f32_dpp v22, v22, v22 row_ror:8 row_mask:0xf bank_mask:0x3
    v_add_f32_dpp v22, v23, v23 row_ror:8 row_mask:0xf bank_mask:0xc
    v_add_f32_dpp v20, v20, v20 row_half_mirror row_mask:0xf bank_mask:0x5
    s_nop 0
    v_add_f32_dpp v20, v22, v22 row_half_mirror row_mask:0xf bank_mask:0xa
    s_addk_i32 s7, 0x2000
    s_waitcnt vmcnt(2)
    buffer_load_dwordx4 v[64:67], v1, s[24:27], s7 offen nt
    s_addk_i32 s7, 0x2000
    s_waitcnt vmcnt(2)
    buffer_load_dwordx4 v[68:71], v1, s[24:27], s7 offen nt
    s_addk_i32 s7, 0x2000
    s_waitcnt vmcnt(2)
    buffer_load_dwordx4 v[72:75], v1, s[24:27], s7 offen nt
    s_addk_i32 s7, 0x2000
    s_waitcnt vmcnt(2)
    buffer_load_dwordx4 v[76:79], v1, s[24:27], s7 offen nt
    v_dot2_f32_bf16 v24, v52, v4, 0
    v_dot2_f32_bf16 v25, v56, v4, 0
    v_dot2_f32_bf16 v26, v60, v4, 0
    v_dot2_f32_bf16 v27, v64, v4, 0
    v_dot2c_f32_bf16 v24, v53, v5
    v_dot2c_f32_bf16 v25, v57, v5
    v_dot2c_f32_bf16 v26, v61, v5
    v_dot2c_f32_bf16 v27, v65, v5
    v_dot2c_f32_bf16 v24, v54, v6
    v_dot2c_f32_bf16 v25, v58, v6
    v_dot2c_f32_bf16 v26, v62, v6
    v_dot2c_f32_bf16 v27, v66, v6
    v_dot2c_f32_bf16 v24, v55, v7
    v_dot2c_f32_bf16 v25, v59, v7
    v_dot2c_f32_bf16 v26, v63, v7
    v_dot2c_f32_bf16 v27, v67, v7
    v_add_f32_dpp v24, v24, v24 row_ror:8 row_mask:0xf bank_mask:0x3
    v_add_f32_dpp v24, v25, v25 row_ror:8 row_mask:0xf bank_mask:0xc
    v_add_f32_dpp v26, v26, v26 row_ror:8 row_mask:0xf bank_mask:0x3
    v_add_f32_dpp v26, v27, v27 row_ror:8 row_mask:0xf bank_mask:0xc
    v_add_f32_dpp v24, v24, v24 row_half_mirror row_mask:0xf bank_mask:0x5
    s_nop 0
    v_add_f32_dpp v24, v26, v26 row_half_mirror row_mask:0xf bank_mask:0xa
    s_addk_i32 s7, 0x2000
    s_waitcnt vmcnt(2)
    buffer_load_dwordx4 v[80:83], v1, s[24:27], s7 offen nt
    s_addk_i32 s7, 0x2000
    s_waitcnt vmcnt(2)
    buffer_load_dwordx4 v[84:87], v1, s[24:27], s7 offen nt
    s_addk_i32 s7, 0x2000
    s_waitcnt vmcnt(2)
    buffer_load_dwordx4 v[88:91], v1, s[24:27], s7 offen nt
    s_addk_i32 s7, 0x2000
    s_waitcnt vmcnt(2)
    buffer_load_dwordx4 v[92:95], v1, s[24:27], s7 offen nt
    v_dot2_f32_bf16 v28, v68, v4, 0
    v_dot2_f32_bf16 v29, v72, v4, 0
    v_dot2_f32_bf16 v30, v76, v4, 0
    v_dot2_f32_bf16 v31, v80, v4, 0
    v_dot2c_f32_bf16 v28, v69, v5
    v_dot2c_f32_bf16 v29, v73, v5
    v_dot2c_f32_bf16 v30, v77, v5
    v_dot2c_f32_bf16 v31, v81, v5
    v_dot2c_f32_bf16 v28, v70, v6
    v_dot2c_f32_bf16 v29, v74, v6
    v_dot2c_f32_bf16 v30, v78, v6
    v_dot2c_f32_bf16 v31, v82, v6
    v_dot2c_f32_bf16 v28, v71, v7
    v_dot2c_f32_bf16 v29, v75, v7
    v_dot2c_f32_bf16 v30, v79, v7
    v_dot2c_f32_bf16 v31, v83, v7
    v_add_f32_dpp v28, v28, v28 row_ror:8 row_mask:0xf bank_mask:0x3
    v_add_f32_dpp v28, v29, v29 row_ror:8 row_mask:0xf bank_mask:0xc
    v_add_f32_dpp v30, v30, v30 row_ror:8 row_mask:0xf bank_mask:0x3
    v_add_f32_dpp v30, v31, v31 row_ror:8 row_mask:0xf bank_mask:0xc
    v_add_f32_dpp v28, v28, v28 row_half_mirror row_mask:0xf bank_mask:0x5
    s_nop 0
    v_add_f32_dpp v28, v30, v30 row_half_mirror row_mask:0xf bank_mask:0xa
    s_addk_i32 s7, 0x2000
    s_waitcnt vmcnt(2)
    buffer_load_dwordx4 v[96:99], v1, s[24:27], s7 offen nt
    s_waitcnt vmcnt(2)
    buffer_load_dwordx4 v[100:103], v1, s[28:31], 0 offen nt
    s_movk_i32 s7, 0x2000
    s_waitcnt vmcnt(2)
    buffer_load_dwordx4 v[104:107], v1, s[28:31], s7 offen nt
    s_movk_i32 s7, 0x4000
    s_waitcnt vmcnt(2)
    buffer_load_dwordx4 v[108:111], v1, s[28:31], s7 offen nt
    s_movk_i32 s7, 0x6000
    buffer_load_dwordx4 v[112:115], v1, s[28:31], s7 offen nt
    s_addk_i32 s7, 0x2000
    buffer_load_dwordx4 v[116:119], v1, s[28:31], s7 offen nt
    s_addk_i32 s7, 0x2000
    buffer_load_dwordx4 v[120:123], v1, s[28:31], s7 offen nt
    s_addk_i32 s7, 0x2000
    buffer_load_dwordx4 v[124:127], v1, s[28:31], s7 offen nt
    v_dot2_f32_bf16 v32, v84, v4, 0
    v_dot2_f32_bf16 v33, v88, v4, 0
    v_dot2_f32_bf16 v34, v92, v4, 0
    v_dot2_f32_bf16 v35, v96, v4, 0
    v_dot2c_f32_bf16 v32, v85, v5
    v_dot2c_f32_bf16 v33, v89, v5
    v_dot2c_f32_bf16 v34, v93, v5
    v_dot2c_f32_bf16 v35, v97, v5
    v_dot2c_f32_bf16 v32, v86, v6
    v_dot2c_f32_bf16 v33, v90, v6
    v_dot2c_f32_bf16 v34, v94, v6
    v_dot2c_f32_bf16 v35, v98, v6
    v_dot2c_f32_bf16 v32, v87, v7
    v_dot2c_f32_bf16 v33, v91, v7
    v_dot2c_f32_bf16 v34, v95, v7
    v_dot2c_f32_bf16 v35, v99, v7
    v_add_f32_dpp v32, v32, v32 row_ror:8 row_mask:0xf bank_mask:0x3
    v_add_f32_dpp v32, v33, v33 row_ror:8 row_mask:0xf bank_mask:0xc
    v_add_f32_dpp v34, v34, v34 row_ror:8 row_mask:0xf bank_mask:0x3
    v_add_f32_dpp v34, v35, v35 row_ror:8 row_mask:0xf bank_mask:0xc
    v_add_f32_dpp v32, v32, v32 row_half_mirror row_mask:0xf bank_mask:0x5
    s_nop 0
    v_add_f32_dpp v32, v34, v34 row_half_mirror row_mask:0xf bank_mask:0xa
    v_cndmask_b32 v22, v28, v20, s[8:9]
    v_cndmask_b32 v26, v32, v24, s[8:9]
    v_cndmask_b32 v21, v20, v28, s[8:9]
    v_cndmask_b32 v25, v24, v32, s[8:9]
    v_add_f32_dpp v21, v22, v21 quad_perm:[2,3,0,1] row_mask:0xf bank_mask:0xf
    v_add_f32_dpp v25, v26, v25 quad_perm:[2,3,0,1] row_mask:0xf bank_mask:0xf
    v_cndmask_b32 v22, v25, v21, s[10:11]
    v_cndmask_b32 v17, v21, v25, s[10:11]
    s_nop 0
    v_add_f32_dpp v17, v22, v17 quad_perm:[1,0,3,2] row_mask:0xf bank_mask:0xf
    s_nop 1
    v_max_f32_dpp v12, v17, v17 row_ror:8 row_mask:0xf bank_mask:0xf
    s_nop 1
    v_max_f32_dpp v12, v12, v12 row_ror:4 row_mask:0xf bank_mask:0xf
    s_nop 1
    v_max_f32_dpp v12, v12, v12 row_ror:2 row_mask:0xf bank_mask:0xf
    s_nop 1
    v_max_f32_dpp v12, v12, v12 row_ror:1 row_mask:0xf bank_mask:0xf
    v_mov_b32 v16, v12
    s_nop 1
    v_permlane16_swap_b32 v12, v16
    s_nop 0
    v_max_f32 v12, v12, v16
    v_mov_b32 v16, v12
    s_nop 1
    v_permlane32_swap_b32 v12, v16
    s_nop 0
    v_max_f32 v12, v12, v16
    v_mul_f32 v12, s12, v12
    v_fma_f32 v17, v17, s12, -v12
    v_exp_f32 v17, v17
    s_nop 0
    v_cvt_pk_bf16_f32 v17, v17, v17
    v_and_b32 v24, 0xffff0000, v17
    s_nop 0
    v_and_b32_dpp v36, v17, v8 row_newbcast:0 row_mask:0xf bank_mask:0xf
    v_and_b32_dpp v37, v17, v9 row_newbcast:0 row_mask:0xf bank_mask:0xf
    v_add_f32_dpp v13, v24, v24 row_ror:8 row_mask:0xf bank_mask:0xf
    v_and_b32_dpp v38, v17, v10 row_newbcast:0 row_mask:0xf bank_mask:0xf
    v_and_b32_dpp v39, v17, v11 row_newbcast:0 row_mask:0xf bank_mask:0xf
    v_add_f32_dpp v13, v13, v13 row_ror:4 row_mask:0xf bank_mask:0xf
    v_and_b32_dpp v40, v17, v8 row_newbcast:8 row_mask:0xf bank_mask:0xf
    v_and_b32_dpp v41, v17, v9 row_newbcast:8 row_mask:0xf bank_mask:0xf
    v_add_f32_dpp v13, v13, v13 row_ror:2 row_mask:0xf bank_mask:0xf
    v_and_b32_dpp v42, v17, v10 row_newbcast:8 row_mask:0xf bank_mask:0xf
    v_and_b32_dpp v43, v17, v11 row_newbcast:8 row_mask:0xf bank_mask:0xf
    v_add_f32_dpp v13, v13, v13 row_ror:1 row_mask:0xf bank_mask:0xf
    v_mov_b32 v16, v13
    v_and_b32_dpp v44, v17, v8 row_newbcast:4 row_mask:0xf bank_mask:0xf
    v_and_b32_dpp v45, v17, v9 row_newbcast:4 row_mask:0xf bank_mask:0xf
    v_permlane16_swap_b32 v13, v16
    v_and_b32_dpp v46, v17, v10 row_newbcast:4 row_mask:0xf bank_mask:0xf
    v_add_f32 v13, v13, v16
    v_mov_b32 v16, v13
    v_and_b32_dpp v47, v17, v11 row_newbcast:4 row_mask:0xf bank_mask:0xf
    v_and_b32_dpp v48, v17, v8 row_newbcast:12 row_mask:0xf bank_mask:0xf
    v_permlane32_swap_b32 v13, v16
    v_and_b32_dpp v49, v17, v9 row_newbcast:12 row_mask:0xf bank_mask:0xf
    v_add_f32 v13, v13, v16
    s_mov_b64 exec, 1
    ds_write_b64 v3, v[12:13]
    s_mov_b64 exec, -1
    v_and_b32_dpp v50, v17, v10 row_newbcast:12 row_mask:0xf bank_mask:0xf
    v_and_b32_dpp v51, v17, v11 row_newbcast:12 row_mask:0xf bank_mask:0xf
    v_and_b32_dpp v52, v17, v8 row_newbcast:1 row_mask:0xf bank_mask:0xf
    v_and_b32_dpp v53, v17, v9 row_newbcast:1 row_mask:0xf bank_mask:0xf
    v_and_b32_dpp v54, v17, v10 row_newbcast:1 row_mask:0xf bank_mask:0xf
    v_and_b32_dpp v55, v17, v11 row_newbcast:1 row_mask:0xf bank_mask:0xf
    v_and_b32_dpp v56, v17, v8 row_newbcast:9 row_mask:0xf bank_mask:0xf
    v_and_b32_dpp v57, v17, v9 row_newbcast:9 row_mask:0xf bank_mask:0xf
    v_and_b32_dpp v58, v17, v10 row_newbcast:9 row_mask:0xf bank_mask:0xf
    v_and_b32_dpp v59, v17, v11 row_newbcast:9 row_mask:0xf bank_mask:0xf
    v_and_b32_dpp v60, v17, v8 row_newbcast:5 row_mask:0xf bank_mask:0xf
    v_and_b32_dpp v61, v17, v9 row_newbcast:5 row_mask:0xf bank_mask:0xf
    v_and_b32_dpp v62, v17, v10 row_newbcast:5 row_mask:0xf bank_mask:0xf
    v_and_b32_dpp v63, v17, v11 row_newbcast:5 row_mask:0xf bank_mask:0xf
    v_and_b32_dpp v64, v17, v8 row_newbcast:13 row_mask:0xf bank_mask:0xf
    v_and_b32_dpp v65, v17, v9 row_newbcast:13 row_mask:0xf bank_mask:0xf
    v_and_b32_dpp v66, v17, v10 row_newbcast:13 row_mask:0xf bank_mask:0xf
    v_and_b32_dpp v67, v17, v11 row_newbcast:13 row_mask:0xf bank_mask:0xf
    s_addk_i32 s7, 0x2000
    s_waitcnt vmcnt(4)
    buffer_load_dwordx4 v[128:131], v1, s[28:31], s7 offen nt
    v_and_b32_dpp v68, v17, v8 row_newbcast:2 row_mask:0xf bank_mask:0xf
    v_and_b32_dpp v69, v17, v9 row_newbcast:2 row_mask:0xf bank_mask:0xf
    v_and_b32_dpp v70, v17, v10 row_newbcast:2 row_mask:0xf bank_mask:0xf
    v_and_b32_dpp v71, v17, v11 row_newbcast:2 row_mask:0xf bank_mask:0xf
    v_and_b32_dpp v72, v17, v8 row_newbcast:10 row_mask:0xf bank_mask:0xf
    v_and_b32_dpp v73, v17, v9 row_newbcast:10 row_mask:0xf bank_mask:0xf
    v_and_b32_dpp v74, v17, v10 row_newbcast:10 row_mask:0xf bank_mask:0xf
    v_and_b32_dpp v75, v17, v11 row_newbcast:10 row_mask:0xf bank_mask:0xf
    v_and_b32_dpp v76, v17, v8 row_newbcast:6 row_mask:0xf bank_mask:0xf
    v_and_b32_dpp v77, v17, v9 row_newbcast:6 row_mask:0xf bank_mask:0xf
    v_and_b32_dpp v78, v17, v10 row_newbcast:6 row_mask:0xf bank_mask:0xf
    v_and_b32_dpp v79, v17, v11 row_newbcast:6 row_mask:0xf bank_mask:0xf
    v_and_b32_dpp v80, v17, v8 row_newbcast:14 row_mask:0xf bank_mask:0xf
    v_and_b32_dpp v81, v17, v9 row_newbcast:14 row_mask:0xf bank_mask:0xf
    v_and_b32_dpp v82, v17, v10 row_newbcast:14 row_mask:0xf bank_mask:0xf
    v_and_b32_dpp v83, v17, v11 row_newbcast:14 row_mask:0xf bank_mask:0xf
    v_and_b32_dpp v84, v17, v8 row_newbcast:3 row_mask:0xf bank_mask:0xf
    v_and_b32_dpp v85, v17, v9 row_newbcast:3 row_mask:0xf bank_mask:0xf
    v_and_b32_dpp v86, v17, v10 row_newbcast:3 row_mask:0xf bank_mask:0xf
    v_and_b32_dpp v87, v17, v11 row_newbcast:3 row_mask:0xf bank_mask:0xf
    v_and_b32_dpp v88, v17, v8 row_newbcast:11 row_mask:0xf bank_mask:0xf
    v_and_b32_dpp v89, v17, v9 row_newbcast:11 row_mask:0xf bank_mask:0xf
    v_and_b32_dpp v90, v17, v10 row_newbcast:11 row_mask:0xf bank_mask:0xf
    v_and_b32_dpp v91, v17, v11 row_newbcast:11 row_mask:0xf bank_mask:0xf
    v_and_b32_dpp v92, v17, v8 row_newbcast:7 row_mask:0xf bank_mask:0xf
    v_and_b32_dpp v93, v17, v9 row_newbcast:7 row_mask:0xf bank_mask:0xf
    v_and_b32_dpp v94, v17, v10 row_newbcast:7 row_mask:0xf bank_mask:0xf
    v_and_b32_dpp v95, v17, v11 row_newbcast:7 row_mask:0xf bank_mask:0xf
    v_and_b32_dpp v96, v17, v8 row_newbcast:15 row_mask:0xf bank_mask:0xf
    v_and_b32_dpp v97, v17, v9 row_newbcast:15 row_mask:0xf bank_mask:0xf
    v_and_b32_dpp v98, v17, v10 row_newbcast:15 row_mask:0xf bank_mask:0xf
    v_and_b32_dpp v99, v17, v11 row_newbcast:15 row_mask:0xf bank_mask:0xf
    s_nop 1
    v_mfma_f32_16x16x32_bf16 v[20:23], v[36:39], v[100:103], 0
    v_mfma_f32_16x16x32_bf16 v[20:23], v[40:43], v[104:107], v[20:23]
    v_mfma_f32_16x16x32_bf16 v[20:23], v[44:47], v[108:111], v[20:23]
    s_addk_i32 s7, 0x2000
    s_waitcnt vmcnt(3)
    buffer_load_dwordx4 v[132:135], v1, s[28:31], s7 offen nt
    v_mfma_f32_16x16x32_bf16 v[20:23], v[48:51], v[112:115], v[20:23]
    v_mfma_f32_16x16x32_bf16 v[20:23], v[52:55], v[116:119], v[20:23]
    s_addk_i32 s7, 0x2000
    s_waitcnt vmcnt(2)
    buffer_load_dwordx4 v[136:139], v1, s[28:31], s7 offen nt
    v_mfma_f32_16x16x32_bf16 v[20:23], v[56:59], v[120:123], v[20:23]
    v_mfma_f32_16x16x32_bf16 v[20:23], v[60:63], v[124:127], v[20:23]
    s_addk_i32 s7, 0x2000
    s_waitcnt vmcnt(2)
    buffer_load_dwordx4 v[140:143], v1, s[28:31], s7 offen nt
    v_mfma_f32_16x16x32_bf16 v[20:23], v[64:67], v[128:131], v[20:23]
    s_addk_i32 s7, 0x2000
    s_waitcnt vmcnt(2)
    buffer_load_dwordx4 v[144:147], v1, s[28:31], s7 offen nt
    s_cmp_eq_u32 s3, 7
    s_cbranch_scc0 L_v20
    s_barrier
L_v20:
    s_mov_b32 s7, 0x18000
    buffer_load_dwordx4 v[148:151], v1, s[28:31], s7 offen nt
    s_mov_b32 s7, 0x1a000
    buffer_load_dwordx4 v[152:155], v1, s[28:31], s7 offen nt
    s_mov_b32 s7, 0x1c000
    buffer_load_dwordx4 v[156:159], v1, s[28:31], s7 offen nt
    s_mov_b32 s7, 0x1e000
    buffer_load_dwordx4 v[160:163], v1, s[28:31], s7 offen nt
    s_cbranch_scc1 L_closer0
    s_barrier
    v_mfma_f32_16x16x32_bf16 v[20:23], v[68:71], v[132:135], v[20:23]
    s_waitcnt vmcnt(6)
    v_mfma_f32_16x16x32_bf16 v[20:23], v[72:75], v[136:139], v[20:23]
    s_waitcnt vmcnt(5)
    v_mfma_f32_16x16x32_bf16 v[20:23], v[76:79], v[140:143], v[20:23]
    s_waitcnt vmcnt(4)
    v_mfma_f32_16x16x32_bf16 v[20:23], v[80:83], v[144:147], v[20:23]
    s_waitcnt vmcnt(3)
    v_mfma_f32_16x16x32_bf16 v[20:23], v[84:87], v[148:151], v[20:23]
    s_waitcnt vmcnt(2)
    v_mfma_f32_16x16x32_bf16 v[20:23], v[88:91], v[152:155], v[20:23]
    s_waitcnt vmcnt(1)
    v_mfma_f32_16x16x32_bf16 v[20:23], v[92:95], v[156:159], v[20:23]
    s_waitcnt vmcnt(0)
    v_mfma_f32_16x16x32_bf16 v[20:23], v[96:99], v[160:163], v[20:23]
    s_nop 7
    ds_write_b64 v2, v[20:21]
    s_waitcnt lgkmcnt(0)
    s_barrier
    s_endpgm
L_closer0:
    v_mov_b32 v19, 0
    s_setprio 3
    v_lshlrev_b32 v2, 3, v0
    s_lshl_b32 s4, s21, 10
    ds_read_b96 v[14:16], v19 offset:96
    ds_read_b128 v[52:55], v19 offset:64
    ds_read_b128 v[56:59], v19 offset:80
    v_lshl_add_u32 v3, v0, 4, s4
    s_waitcnt lgkmcnt(0)
    v_readfirstlane_b32 s20, v16
    v_mfma_f32_16x16x32_bf16 v[20:23], v[68:71], v[132:135], v[20:23]
    s_waitcnt vmcnt(6)
    v_mfma_f32_16x16x32_bf16 v[20:23], v[72:75], v[136:139], v[20:23]
    s_waitcnt vmcnt(5)
    v_mfma_f32_16x16x32_bf16 v[20:23], v[76:79], v[140:143], v[20:23]
    s_waitcnt vmcnt(4)
    v_mfma_f32_16x16x32_bf16 v[20:23], v[80:83], v[144:147], v[20:23]
    s_waitcnt vmcnt(3)
    v_mfma_f32_16x16x32_bf16 v[20:23], v[84:87], v[148:151], v[20:23]
    s_branch L_ctail
L_k1:
    s_movk_i32 s7, 0x6000
    buffer_load_dwordx4 v[48:51], v1, s[24:27], s7 offen nt
    s_load_dwordx2 s[40:41], s[0:1], 64
    s_mov_b32 s30, 0x2000000
    s_mov_b32 s31, 0x20000
    v_and_b32 v3, 1, v0
    v_mov_b32 v2, 0xffff
    v_lshlrev_b32 v3, 4, v3
    v_lshlrev_b32 v2, v3, v2
    v_bfe_u32 v3, v0, 1, 3
    v_cmp_eq_u32 s[8:9], 0, v3
    v_cmp_eq_u32 s[10:11], 2, v3
    v_cmp_eq_u32 s[12:13], 4, v3
    v_cmp_eq_u32 s[14:15], 6, v3
    s_lshl_b32 s4, s3, 9
    s_add_u32 s4, s4, 512
    s_lshl_b32 s5, s3, 3
    s_mov_b32 s42, 0x100000
    s_mov_b32 s43, 0x20000
    v_cndmask_b32 v8, 0, v2, s[8:9]
    v_cndmask_b32 v9, 0, v2, s[10:11]
    v_cndmask_b32 v10, 0, v2, s[12:13]
    v_cndmask_b32 v11, 0, v2, s[14:15]
    v_lshl_add_u32 v2, v0, 3, s4
    v_mov_b32 v3, s5
    s_mov_b32 s8, 0xcccccccc
    s_mov_b32 s9, 0xcccccccc
    s_mov_b32 s10, 0xaaaaaaaa
    s_mov_b32 s11, 0xaaaaaaaa
    s_mov_b32 s12, 0x3e0293ee
    s_barrier
    s_addk_i32 s7, 0x2000
    s_waitcnt vmcnt(3)
    buffer_load_dwordx4 v[52:55], v1, s[24:27], s7 offen nt
    s_addk_i32 s7, 0x2000
    s_waitcnt vmcnt(3)
    buffer_load_dwordx4 v[56:59], v1, s[24:27], s7 offen nt
    s_addk_i32 s7, 0x2000
    s_waitcnt vmcnt(3)
    buffer_load_dwordx4 v[60:63], v1, s[24:27], s7 offen nt
    s_addk_i32 s7, 0x2000
    s_waitcnt vmcnt(3)
    buffer_load_dwordx4 v[64:67], v1, s[24:27], s7 offen nt
    v_dot2_f32_bf16 v20, v36, v4, 0
    v_dot2_f32_bf16 v21, v40, v4, 0
    v_dot2_f32_bf16 v22, v44, v4, 0
    v_dot2_f32_bf16 v23, v48, v4, 0
    v_dot2c_f32_bf16 v20, v37, v5
    v_dot2c_f32_bf16 v21, v41, v5
    v_dot2c_f32_bf16 v22, v45, v5
    v_dot2c_f32_bf16 v23, v49, v5
    v_dot2c_f32_bf16 v20, v38, v6
    v_dot2c_f32_bf16 v21, v42, v6
    v_dot2c_f32_bf16 v22, v46, v6
    v_dot2c_f32_bf16 v23, v50, v6
    v_dot2c_f32_bf16 v20, v39, v7
    v_dot2c_f32_bf16 v21, v43, v7
    v_dot2c_f32_bf16 v22, v47, v7
    v_dot2c_f32_bf16 v23, v51, v7
    v_add_f32_dpp v20, v20, v20 row_ror:8 row_mask:0xf bank_mask:0x3
    v_add_f32_dpp v20, v21, v21 row_ror:8 row_mask:0xf bank_mask:0xc
    v_add_f32_dpp v22, v22, v22 row_ror:8 row_mask:0xf bank_mask:0x3
    v_add_f32_dpp v22, v23, v23 row_ror:8 row_mask:0xf bank_mask:0xc
    v_add_f32_dpp v20, v20, v20 row_half_mirror row_mask:0xf bank_mask:0x5
    s_nop 0
    v_add_f32_dpp v20, v22, v22 row_half_mirror row_mask:0xf bank_mask:0xa
    s_addk_i32 s7, 0x2000
    s_waitcnt vmcnt(3)
    buffer_load_dwordx4 v[68:71], v1, s[24:27], s7 offen nt
    s_addk_i32 s7, 0x2000
    s_waitcnt vmcnt(3)
    buffer_load_dwordx4 v[72:75], v1, s[24:27], s7 offen nt
    s_addk_i32 s7, 0x2000
    s_waitcnt vmcnt(3)
    buffer_load_dwordx4 v[76:79], v1, s[24:27], s7 offen nt
    s_addk_i32 s7, 0x2000
    s_waitcnt vmcnt(3)
    buffer_load_dwordx4 v[80:83], v1, s[24:27], s7 offen nt
    v_dot2_f32_bf16 v24, v52, v4, 0
    v_dot2_f32_bf16 v25, v56, v4, 0
    v_dot2_f32_bf16 v26, v60, v4, 0
    v_dot2_f32_bf16 v27, v64, v4, 0
    v_dot2c_f32_bf16 v24, v53, v5
    v_dot2c_f32_bf16 v25, v57, v5
    v_dot2c_f32_bf16 v26, v61, v5
    v_dot2c_f32_bf16 v27, v65, v5
    v_dot2c_f32_bf16 v24, v54, v6
    v_dot2c_f32_bf16 v25, v58, v6
    v_dot2c_f32_bf16 v26, v62, v6
    v_dot2c_f32_bf16 v27, v66, v6
    v_dot2c_f32_bf16 v24, v55, v7
    v_dot2c_f32_bf16 v25, v59, v7
    v_dot2c_f32_bf16 v26, v63, v7
    v_dot2c_f32_bf16 v27, v67, v7
    v_add_f32_dpp v24, v24, v24 row_ror:8 row_mask:0xf bank_mask:0x3
    v_add_f32_dpp v24, v25, v25 row_ror:8 row_mask:0xf bank_mask:0xc
    v_add_f32_dpp v26, v26, v26 row_ror:8 row_mask:0xf bank_mask:0x3
    v_add_f32_dpp v26, v27, v27 row_ror:8 row_mask:0xf bank_mask:0xc
    v_add_f32_dpp v24, v24, v24 row_half_mirror row_mask:0xf bank_mask:0x5
    s_nop 0
    v_add_f32_dpp v24, v26, v26 row_half_mirror row_mask:0xf bank_mask:0xa
    s_addk_i32 s7, 0x2000
    s_waitcnt vmcnt(3)
    buffer_load_dwordx4 v[84:87], v1, s[24:27], s7 offen nt
    s_addk_i32 s7, 0x2000
    s_waitcnt vmcnt(3)
    buffer_load_dwordx4 v[88:91], v1, s[24:27], s7 offen nt
    s_addk_i32 s7, 0x2000
    s_waitcnt vmcnt(3)
    buffer_load_dwordx4 v[92:95], v1, s[24:27], s7 offen nt
    s_addk_i32 s7, 0x2000
    s_waitcnt vmcnt(3)
    buffer_load_dwordx4 v[96:99], v1, s[24:27], s7 offen nt
    v_dot2_f32_bf16 v28, v68, v4, 0
    v_dot2_f32_bf16 v29, v72, v4, 0
    v_dot2_f32_bf16 v30, v76, v4, 0
    v_dot2_f32_bf16 v31, v80, v4, 0
    v_dot2c_f32_bf16 v28, v69, v5
    v_dot2c_f32_bf16 v29, v73, v5
    v_dot2c_f32_bf16 v30, v77, v5
    v_dot2c_f32_bf16 v31, v81, v5
    v_dot2c_f32_bf16 v28, v70, v6
    v_dot2c_f32_bf16 v29, v74, v6
    v_dot2c_f32_bf16 v30, v78, v6
    v_dot2c_f32_bf16 v31, v82, v6
    v_dot2c_f32_bf16 v28, v71, v7
    v_dot2c_f32_bf16 v29, v75, v7
    v_dot2c_f32_bf16 v30, v79, v7
    v_dot2c_f32_bf16 v31, v83, v7
    v_add_f32_dpp v28, v28, v28 row_ror:8 row_mask:0xf bank_mask:0x3
    v_add_f32_dpp v28, v29, v29 row_ror:8 row_mask:0xf bank_mask:0xc
    v_add_f32_dpp v30, v30, v30 row_ror:8 row_mask:0xf bank_mask:0x3
    v_add_f32_dpp v30, v31, v31 row_ror:8 row_mask:0xf bank_mask:0xc
    v_add_f32_dpp v28, v28, v28 row_half_mirror row_mask:0xf bank_mask:0x5
    s_nop 0
    v_add_f32_dpp v28, v30, v30 row_half_mirror row_mask:0xf bank_mask:0xa
    s_waitcnt vmcnt(3)
    buffer_load_dwordx4 v[100:103], v1, s[28:31], 0 offen nt
    s_movk_i32 s7, 0x2000
    s_waitcnt vmcnt(3)
    buffer_load_dwordx4 v[104:107], v1, s[28:31], s7 offen nt
    s_movk_i32 s7, 0x4000
    s_waitcnt vmcnt(3)
    buffer_load_dwordx4 v[108:111], v1, s[28:31], s7 offen nt
    s_movk_i32 s7, 0x6000
    s_waitcnt vmcnt(3)
    buffer_load_dwordx4 v[112:115], v1, s[28:31], s7 offen nt
    s_addk_i32 s7, 0x2000
    buffer_load_dwordx4 v[116:119], v1, s[28:31], s7 offen nt
    s_addk_i32 s7, 0x2000
    buffer_load_dwordx4 v[120:123], v1, s[28:31], s7 offen nt
    s_addk_i32 s7, 0x2000
    buffer_load_dwordx4 v[124:127], v1, s[28:31], s7 offen nt
    v_dot2_f32_bf16 v32, v84, v4, 0
    v_dot2_f32_bf16 v33, v88, v4, 0
    v_dot2_f32_bf16 v34, v92, v4, 0
    v_dot2_f32_bf16 v35, v96, v4, 0
    v_dot2c_f32_bf16 v32, v85, v5
    v_dot2c_f32_bf16 v33, v89, v5
    v_dot2c_f32_bf16 v34, v93, v5
    v_dot2c_f32_bf16 v35, v97, v5
    v_dot2c_f32_bf16 v32, v86, v6
    v_dot2c_f32_bf16 v33, v90, v6
    v_dot2c_f32_bf16 v34, v94, v6
    v_dot2c_f32_bf16 v35, v98, v6
    v_dot2c_f32_bf16 v32, v87, v7
    v_dot2c_f32_bf16 v33, v91, v7
    v_dot2c_f32_bf16 v34, v95, v7
    v_dot2c_f32_bf16 v35, v99, v7
    v_add_f32_dpp v32, v32, v32 row_ror:8 row_mask:0xf bank_mask:0x3
    v_add_f32_dpp v32, v33, v33 row_ror:8 row_mask:0xf bank_mask:0xc
    v_add_f32_dpp v34, v34, v34 row_ror:8 row_mask:0xf bank_mask:0x3
    v_add_f32_dpp v34, v35, v35 row_ror:8 row_mask:0xf bank_mask:0xc
    v_add_f32_dpp v32, v32, v32 row_half_mirror row_mask:0xf bank_mask:0x5
    s_nop 0
    v_add_f32_dpp v32, v34, v34 row_half_mirror row_mask:0xf bank_mask:0xa
    v_cndmask_b32 v22, v28, v20, s[8:9]
    v_cndmask_b32 v26, v32, v24, s[8:9]
    v_cndmask_b32 v21, v20, v28, s[8:9]
    v_cndmask_b32 v25, v24, v32, s[8:9]
    v_add_f32_dpp v21, v22, v21 quad_perm:[2,3,0,1] row_mask:0xf bank_mask:0xf
    v_add_f32_dpp v25, v26, v25 quad_perm:[2,3,0,1] row_mask:0xf bank_mask:0xf
    v_cndmask_b32 v22, v25, v21, s[10:11]
    v_cndmask_b32 v17, v21, v25, s[10:11]
    s_nop 0
    v_add_f32_dpp v17, v22, v17 quad_perm:[1,0,3,2] row_mask:0xf bank_mask:0xf
    s_nop 1
    v_max_f32_dpp v12, v17, v17 row_ror:8 row_mask:0xf bank_mask:0xf
    s_nop 1
    v_max_f32_dpp v12, v12, v12 row_ror:4 row_mask:0xf bank_mask:0xf
    s_nop 1
    v_max_f32_dpp v12, v12, v12 row_ror:2 row_mask:0xf bank_mask:0xf
    s_nop 1
    v_max_f32_dpp v12, v12, v12 row_ror:1 row_mask:0xf bank_mask:0xf
    v_mov_b32 v16, v12
    s_nop 1
    v_permlane16_swap_b32 v12, v16
    s_nop 0
    v_max_f32 v12, v12, v16
    v_mov_b32 v16, v12
    s_nop 1
    v_permlane32_swap_b32 v12, v16
    s_nop 0
    v_max_f32 v12, v12, v16
    v_mul_f32 v12, s12, v12
    v_fma_f32 v17, v17, s12, -v12
    v_exp_f32 v17, v17
    s_nop 0
    v_cvt_pk_bf16_f32 v17, v17, v17
    v_and_b32 v24, 0xffff0000, v17
    s_nop 0
    v_and_b32_dpp v36, v17, v8 row_newbcast:0 row_mask:0xf bank_mask:0xf
    v_and_b32_dpp v37, v17, v9 row_newbcast:0 row_mask:0xf bank_mask:0xf
    v_add_f32_dpp v13, v24, v24 row_ror:8 row_mask:0xf bank_mask:0xf
    v_and_b32_dpp v38, v17, v10 row_newbcast:0 row_mask:0xf bank_mask:0xf
    v_and_b32_dpp v39, v17, v11 row_newbcast:0 row_mask:0xf bank_mask:0xf
    v_add_f32_dpp v13, v13, v13 row_ror:4 row_mask:0xf bank_mask:0xf
    v_and_b32_dpp v40, v17, v8 row_newbcast:8 row_mask:0xf bank_mask:0xf
    v_and_b32_dpp v41, v17, v9 row_newbcast:8 row_mask:0xf bank_mask:0xf
    v_add_f32_dpp v13, v13, v13 row_ror:2 row_mask:0xf bank_mask:0xf
    v_and_b32_dpp v42, v17, v10 row_newbcast:8 row_mask:0xf bank_mask:0xf
    v_and_b32_dpp v43, v17, v11 row_newbcast:8 row_mask:0xf bank_mask:0xf
    v_add_f32_dpp v13, v13, v13 row_ror:1 row_mask:0xf bank_mask:0xf
    v_mov_b32 v16, v13
    v_and_b32_dpp v44, v17, v8 row_newbcast:4 row_mask:0xf bank_mask:0xf
    v_and_b32_dpp v45, v17, v9 row_newbcast:4 row_mask:0xf bank_mask:0xf
    v_permlane16_swap_b32 v13, v16
    v_and_b32_dpp v46, v17, v10 row_newbcast:4 row_mask:0xf bank_mask:0xf
    v_add_f32 v13, v13, v16
    v_mov_b32 v16, v13
    v_and_b32_dpp v47, v17, v11 row_newbcast:4 row_mask:0xf bank_mask:0xf
    v_and_b32_dpp v48, v17, v8 row_newbcast:12 row_mask:0xf bank_mask:0xf
    v_permlane32_swap_b32 v13, v16
    v_and_b32_dpp v49, v17, v9 row_newbcast:12 row_mask:0xf bank_mask:0xf
    v_add_f32 v13, v13, v16
    s_mov_b64 exec, 1
    ds_write_b64 v3, v[12:13]
    s_mov_b64 exec, -1
    v_and_b32_dpp v50, v17, v10 row_newbcast:12 row_mask:0xf bank_mask:0xf
    v_and_b32_dpp v51, v17, v11 row_newbcast:12 row_mask:0xf bank_mask:0xf
    v_and_b32_dpp v52, v17, v8 row_newbcast:1 row_mask:0xf bank_mask:0xf
    v_and_b32_dpp v53, v17, v9 row_newbcast:1 row_mask:0xf bank_mask:0xf
    v_and_b32_dpp v54, v17, v10 row_newbcast:1 row_mask:0xf bank_mask:0xf
    v_and_b32_dpp v55, v17, v11 row_newbcast:1 row_mask:0xf bank_mask:0xf
    v_and_b32_dpp v56, v17, v8 row_newbcast:9 row_mask:0xf bank_mask:0xf
    v_and_b32_dpp v57, v17, v9 row_newbcast:9 row_mask:0xf bank_mask:0xf
    v_and_b32_dpp v58, v17, v10 row_newbcast:9 row_mask:0xf bank_mask:0xf
    v_and_b32_dpp v59, v17, v11 row_newbcast:9 row_mask:0xf bank_mask:0xf
    v_and_b32_dpp v60, v17, v8 row_newbcast:5 row_mask:0xf bank_mask:0xf
    v_and_b32_dpp v61, v17, v9 row_newbcast:5 row_mask:0xf bank_mask:0xf
    v_and_b32_dpp v62, v17, v10 row_newbcast:5 row_mask:0xf bank_mask:0xf
    v_and_b32_dpp v63, v17, v11 row_newbcast:5 row_mask:0xf bank_mask:0xf
    v_and_b32_dpp v64, v17, v8 row_newbcast:13 row_mask:0xf bank_mask:0xf
    v_and_b32_dpp v65, v17, v9 row_newbcast:13 row_mask:0xf bank_mask:0xf
    v_and_b32_dpp v66, v17, v10 row_newbcast:13 row_mask:0xf bank_mask:0xf
    v_and_b32_dpp v67, v17, v11 row_newbcast:13 row_mask:0xf bank_mask:0xf
    s_addk_i32 s7, 0x2000
    s_waitcnt vmcnt(4)
    buffer_load_dwordx4 v[128:131], v1, s[28:31], s7 offen nt
    v_and_b32_dpp v68, v17, v8 row_newbcast:2 row_mask:0xf bank_mask:0xf
    v_and_b32_dpp v69, v17, v9 row_newbcast:2 row_mask:0xf bank_mask:0xf
    v_and_b32_dpp v70, v17, v10 row_newbcast:2 row_mask:0xf bank_mask:0xf
    v_and_b32_dpp v71, v17, v11 row_newbcast:2 row_mask:0xf bank_mask:0xf
    v_and_b32_dpp v72, v17, v8 row_newbcast:10 row_mask:0xf bank_mask:0xf
    v_and_b32_dpp v73, v17, v9 row_newbcast:10 row_mask:0xf bank_mask:0xf
    v_and_b32_dpp v74, v17, v10 row_newbcast:10 row_mask:0xf bank_mask:0xf
    v_and_b32_dpp v75, v17, v11 row_newbcast:10 row_mask:0xf bank_mask:0xf
    v_and_b32_dpp v76, v17, v8 row_newbcast:6 row_mask:0xf bank_mask:0xf
    v_and_b32_dpp v77, v17, v9 row_newbcast:6 row_mask:0xf bank_mask:0xf
    v_and_b32_dpp v78, v17, v10 row_newbcast:6 row_mask:0xf bank_mask:0xf
    v_and_b32_dpp v79, v17, v11 row_newbcast:6 row_mask:0xf bank_mask:0xf
    v_and_b32_dpp v80, v17, v8 row_newbcast:14 row_mask:0xf bank_mask:0xf
    v_and_b32_dpp v81, v17, v9 row_newbcast:14 row_mask:0xf bank_mask:0xf
    v_and_b32_dpp v82, v17, v10 row_newbcast:14 row_mask:0xf bank_mask:0xf
    v_and_b32_dpp v83, v17, v11 row_newbcast:14 row_mask:0xf bank_mask:0xf
    v_and_b32_dpp v84, v17, v8 row_newbcast:3 row_mask:0xf bank_mask:0xf
    v_and_b32_dpp v85, v17, v9 row_newbcast:3 row_mask:0xf bank_mask:0xf
    v_and_b32_dpp v86, v17, v10 row_newbcast:3 row_mask:0xf bank_mask:0xf
    v_and_b32_dpp v87, v17, v11 row_newbcast:3 row_mask:0xf bank_mask:0xf
    v_and_b32_dpp v88, v17, v8 row_newbcast:11 row_mask:0xf bank_mask:0xf
    v_and_b32_dpp v89, v17, v9 row_newbcast:11 row_mask:0xf bank_mask:0xf
    v_and_b32_dpp v90, v17, v10 row_newbcast:11 row_mask:0xf bank_mask:0xf
    v_and_b32_dpp v91, v17, v11 row_newbcast:11 row_mask:0xf bank_mask:0xf
    v_and_b32_dpp v92, v17, v8 row_newbcast:7 row_mask:0xf bank_mask:0xf
    v_and_b32_dpp v93, v17, v9 row_newbcast:7 row_mask:0xf bank_mask:0xf
    v_and_b32_dpp v94, v17, v10 row_newbcast:7 row_mask:0xf bank_mask:0xf
    v_and_b32_dpp v95, v17, v11 row_newbcast:7 row_mask:0xf bank_mask:0xf
    v_and_b32_dpp v96, v17, v8 row_newbcast:15 row_mask:0xf bank_mask:0xf
    v_and_b32_dpp v97, v17, v9 row_newbcast:15 row_mask:0xf bank_mask:0xf
    v_and_b32_dpp v98, v17, v10 row_newbcast:15 row_mask:0xf bank_mask:0xf
    v_and_b32_dpp v99, v17, v11 row_newbcast:15 row_mask:0xf bank_mask:0xf
    s_nop 1
    v_mfma_f32_16x16x32_bf16 v[20:23], v[36:39], v[100:103], 0
    v_mfma_f32_16x16x32_bf16 v[20:23], v[40:43], v[104:107], v[20:23]
    v_mfma_f32_16x16x32_bf16 v[20:23], v[44:47], v[108:111], v[20:23]
    s_addk_i32 s7, 0x2000
    s_waitcnt vmcnt(3)
    buffer_load_dwordx4 v[132:135], v1, s[28:31], s7 offen nt
    v_mfma_f32_16x16x32_bf16 v[20:23], v[48:51], v[112:115], v[20:23]
    v_mfma_f32_16x16x32_bf16 v[20:23], v[52:55], v[116:119], v[20:23]
    s_addk_i32 s7, 0x2000
    s_waitcnt vmcnt(3)
    buffer_load_dwordx4 v[136:139], v1, s[28:31], s7 offen nt
    v_mfma_f32_16x16x32_bf16 v[20:23], v[56:59], v[120:123], v[20:23]
    s_addk_i32 s7, 0x2000
    s_waitcnt vmcnt(3)
    buffer_load_dwordx4 v[140:143], v1, s[28:31], s7 offen nt
    v_mfma_f32_16x16x32_bf16 v[20:23], v[60:63], v[124:127], v[20:23]
    s_addk_i32 s7, 0x2000
    s_waitcnt vmcnt(3)
    buffer_load_dwordx4 v[144:147], v1, s[28:31], s7 offen nt
    s_cmp_eq_u32 s3, 7
    s_cbranch_scc0 L_v21
    s_barrier
L_v21:
    s_mov_b32 s7, 0x18000
    buffer_load_dwordx4 v[148:151], v1, s[28:31], s7 offen nt
    s_mov_b32 s7, 0x1a000
    buffer_load_dwordx4 v[152:155], v1, s[28:31], s7 offen nt
    s_mov_b32 s7, 0x1c000
    buffer_load_dwordx4 v[156:159], v1, s[28:31], s7 offen nt
    s_mov_b32 s7, 0x1e000
    buffer_load_dwordx4 v[160:163], v1, s[28:31], s7 offen nt
    s_cbranch_scc1 L_closer1
    s_barrier
    v_mfma_f32_16x16x32_bf16 v[20:23], v[64:67], v[128:131], v[20:23]
    s_waitcnt vmcnt(7)
    v_mfma_f32_16x16x32_bf16 v[20:23], v[68:71], v[132:135], v[20:23]
    s_waitcnt vmcnt(6)
    v_mfma_f32_16x16x32_bf16 v[20:23], v[72:75], v[136:139], v[20:23]
    s_waitcnt vmcnt(5)
    v_mfma_f32_16x16x32_bf16 v[20:23], v[76:79], v[140:143], v[20:23]
    s_waitcnt vmcnt(4)
    v_mfma_f32_16x16x32_bf16 v[20:23], v[80:83], v[144:147], v[20:23]
    s_waitcnt vmcnt(3)
    v_mfma_f32_16x16x32_bf16 v[20:23], v[84:87], v[148:151], v[20:23]
    s_waitcnt vmcnt(2)
    v_mfma_f32_16x16x32_bf16 v[20:23], v[88:91], v[152:155], v[20:23]
    s_waitcnt vmcnt(1)
    v_mfma_f32_16x16x32_bf16 v[20:23], v[92:95], v[156:159], v[20:23]
    s_waitcnt vmcnt(0)
    v_mfma_f32_16x16x32_bf16 v[20:23], v[96:99], v[160:163], v[20:23]
    s_nop 7
    ds_write_b64 v2, v[20:21]
    s_waitcnt lgkmcnt(0)
    s_barrier
    s_endpgm
L_closer1:
    v_mov_b32 v19, 0
    s_setprio 3
    v_lshlrev_b32 v2, 3, v0
    s_lshl_b32 s4, s21, 10
    ds_read_b96 v[14:16], v19 offset:96
    ds_read_b128 v[52:55], v19 offset:64
    ds_read_b128 v[56:59], v19 offset:80
    v_lshl_add_u32 v3, v0, 4, s4
    s_waitcnt lgkmcnt(0)
    v_readfirstlane_b32 s20, v16
    v_mfma_f32_16x16x32_bf16 v[20:23], v[64:67], v[128:131], v[20:23]
    s_waitcnt vmcnt(7)
    v_mfma_f32_16x16x32_bf16 v[20:23], v[68:71], v[132:135], v[20:23]
    s_waitcnt vmcnt(6)
    v_mfma_f32_16x16x32_bf16 v[20:23], v[72:75], v[136:139], v[20:23]
    s_waitcnt vmcnt(5)
    v_mfma_f32_16x16x32_bf16 v[20:23], v[76:79], v[140:143], v[20:23]
    s_waitcnt vmcnt(4)
    v_mfma_f32_16x16x32_bf16 v[20:23], v[80:83], v[144:147], v[20:23]
    s_waitcnt vmcnt(3)
    v_mfma_f32_16x16x32_bf16 v[20:23], v[84:87], v[148:151], v[20:23]
L_ctail:
    s_cmp_eq_u32 s20, 1
    s_barrier
    ds_read2st64_b64 v[36:39], v2 offset0:1 offset1:2
    ds_read2st64_b64 v[40:43], v2 offset0:3 offset1:4
    ds_read2st64_b64 v[44:47], v2 offset0:5 offset1:6
    ds_read_b64 v[48:49], v2 offset:3584
    s_waitcnt vmcnt(2)
    v_mfma_f32_16x16x32_bf16 v[20:23], v[88:91], v[152:155], v[20:23]
    s_waitcnt vmcnt(1)
    v_mfma_f32_16x16x32_bf16 v[20:23], v[92:95], v[156:159], v[20:23]
    s_waitcnt lgkmcnt(0)
    v_pk_mul_f32 v[36:37], v[36:37], v[52:53] op_sel:[0,0] op_sel_hi:[1,0]
    v_pk_mul_f32 v[38:39], v[38:39], v[52:53] op_sel:[0,1] op_sel_hi:[1,1]
    v_pk_fma_f32 v[36:37], v[40:41], v[54:55], v[36:37] op_sel:[0,0,0] op_sel_hi:[1,0,1]
    v_pk_fma_f32 v[38:39], v[42:43], v[54:55], v[38:39] op_sel:[0,1,0] op_sel_hi:[1,1,1]
    v_pk_fma_f32 v[36:37], v[44:45], v[56:57], v[36:37] op_sel:[0,0,0] op_sel_hi:[1,0,1]
    v_pk_fma_f32 v[38:39], v[46:47], v[56:57], v[38:39] op_sel:[0,1,0] op_sel_hi:[1,1,1]
    v_pk_fma_f32 v[36:37], v[48:49], v[58:59], v[36:37] op_sel:[0,0,0] op_sel_hi:[1,0,1]
    v_pk_add_f32 v[36:37], v[36:37], v[38:39]
    s_waitcnt vmcnt(0)
    v_mfma_f32_16x16x32_bf16 v[20:23], v[96:99], v[160:163], v[20:23]
    s_cbranch_scc0 L_o_far
    s_nop 6
    v_pk_fma_f32 v[12:13], v[20:21], v[58:59], v[36:37] op_sel:[0,1,0] op_sel_hi:[1,1,1]
    buffer_store_dwordx4 v[12:15], v3, s[40:43], 0 offen
    s_endpgm
L_o_far:
    s_nop 6
    v_pk_fma_f32 v[12:13], v[20:21], v[58:59], v[36:37] op_sel:[0,1,0] op_sel_hi:[1,1,1]
    buffer_store_dwordx4 v[12:15], v3, s[40:43], 0 offen sc1
    s_endpgm
L_helper:
    v_and_b32 v14, 7, v0
    v_mov_b32 v9, 0
    v_mov_b32 v8, 0
    v_lshlrev_b32 v15, 3, v14
    s_load_dwordx2 s[40:41], s[0:1], 64
    s_load_dwordx2 s[48:49], s[0:1], 48
    ds_write_b64 v15, v[8:9]
    s_load_dwordx2 s[52:53], s[0:1], 24
    s_load_dwordx2 s[56:57], s[0:1], 32
    s_load_dwordx2 s[88:89], s[0:1], 40
    s_mov_b32 s42, 0x100000
    s_mov_b32 s43, 0x20000
    s_mov_b32 s50, 8192
    s_mov_b32 s51, 0x20000
    s_mov_b32 s54, 8192
    s_mov_b32 s55, 0x20000
    s_mov_b32 s58, 8192
    s_mov_b32 s59, 0x20000
    s_and_b32 s23, s21, 7
    s_mul_i32 s4, s22, 4352
    s_add_u32 s6, s4, 0xa0000
    s_add_u32 s61, s4, 0x60000
    s_lshl_b32 s7, s22, 8
    v_lshl_add_u32 v4, v0, 2, s7
    v_bfe_u32 v5, v0, 2, 2
    v_lshrrev_b32 v6, 5, v0
    v_lshl_add_u32 v5, v6, 2, v5
    v_and_b32 v7, 3, v0
    v_bfe_u32 v8, v0, 4, 1
    v_lshl_add_u32 v7, v8, 2, v7
    s_getreg_b32 s20, hwreg(HW_REG_XCC_ID, 0, 4)
    s_waitcnt lgkmcnt(0)
    s_load_dwordx2 s[36:37], s[40:41], s6
    s_barrier
    buffer_load_dword v10, v4, s[32:35], 0 offen
    buffer_load_dword v11, v4, s[52:55], 0 offen
    s_and_b32 s4, s23, 1
    s_lshl_b32 s4, s4, 7
    s_lshr_b32 s5, s23, 1
    s_lshl_b32 s5, s5, 2
    s_add_u32 s4, s4, s5
    s_add_u32 s4, s4, s7
    v_lshl_add_u32 v3, v7, 4, s4
    buffer_load_dword v12, v3, s[56:59], 0 offen
    global_load_ushort v13, v9, s[88:89]
    v_lshl_add_u32 v3, v6, 1, v3
    s_lshl_b32 s4, s22, 13
    s_lshl_b32 s5, s23, 7
    s_add_u32 s4, s4, s5
    v_lshlrev_b32 v7, 4, v7
    v_lshl_add_u32 v1, v5, 10, v7
    v_add_u32 v1, s4, v1
    v_cmp_eq_u32 s[44:45], 0, v5
    s_lshl_b32 s4, s22, 7
    s_add_u32 s4, s4, 0x40000
    v_lshl_add_u32 v2, v5, 4, s4
    s_lshl_b32 s5, s23, 4
    s_add_u32 s4, s4, s5
    v_mov_b32 v19, s4
    s_lshl_b32 s4, s23, 3
    s_add_u32 s4, s4, s61
    v_mov_b32 v4, s4
    v_mov_b32 v8, s6
    v_lshlrev_b32 v14, 2, v14
    s_waitcnt lgkmcnt(0)
    s_add_u32 s36, s36, 1
    s_and_b32 s39, s37, -16
    s_or_b32 s39, s39, s20
    s_mov_b32 s38, s36
    v_mov_b32 v6, s38
    v_mov_b32 v7, s39
    s_mov_b64 exec, 1
    buffer_store_dwordx2 v[6:7], v4, s[40:43], 0 offen sc1
    s_mov_b64 exec, -1
    s_waitcnt vmcnt(0)
    buffer_load_dword v40, v2, s[40:43], 0 offen sc1
    buffer_load_dword v41, v1, s[40:43], 0 offen sc1
    v_dot2_f32_bf16 v10, v10, v11, 0
    v_lshlrev_b32 v13, 16, v13
    v_sub_f32 v13, 1.0, v13
    v_cndmask_b32 v12, 0, v12, s[44:45]
    s_nop 1
    v_add_f32_dpp v10, v10, v10 row_ror:8 row_mask:0xf bank_mask:0xf
    s_nop 1
    v_add_f32_dpp v10, v10, v10 row_ror:4 row_mask:0xf bank_mask:0xf
    s_nop 1
    v_add_f32_dpp v10, v10, v10 row_ror:2 row_mask:0xf bank_mask:0xf
    s_nop 1
    v_add_f32_dpp v10, v10, v10 row_ror:1 row_mask:0xf bank_mask:0xf
    v_mov_b32 v11, v10
    s_nop 1
    v_permlane16_swap_b32 v10, v11
    s_nop 0
    v_add_f32 v10, v10, v11
    v_mov_b32 v11, v10
    s_nop 1
    v_permlane32_swap_b32 v10, v11
    s_nop 0
    v_add_f32 v10, v10, v11
    v_mul_f32 v10, 0x3e0293ee, v10
    v_mul_f32 v13, 0xceabfb8f, v13
    v_add_f32 v10, v10, v13
    v_and_b32 v13, 0xffff0000, v12
    v_lshlrev_b32 v12, 16, v12
    s_mov_b32 s60, 5
L_an:
    s_load_dwordx16 s[4:19], s[40:41], s61 glc
    s_waitcnt lgkmcnt(0)
    s_xor_b64 s[4:5], s[4:5], s[38:39]
    s_xor_b64 s[6:7], s[6:7], s[38:39]
    s_xor_b64 s[8:9], s[8:9], s[38:39]
    s_xor_b64 s[10:11], s[10:11], s[38:39]
    s_xor_b64 s[12:13], s[12:13], s[38:39]
    s_xor_b64 s[14:15], s[14:15], s[38:39]
    s_xor_b64 s[16:17], s[16:17], s[38:39]
    s_xor_b64 s[18:19], s[18:19], s[38:39]
    s_or_b64 s[4:5], s[4:5], s[6:7]
    s_or_b64 s[8:9], s[8:9], s[10:11]
    s_or_b64 s[12:13], s[12:13], s[14:15]
    s_or_b64 s[16:17], s[16:17], s[18:19]
    s_or_b64 s[4:5], s[4:5], s[8:9]
    s_or_b64 s[12:13], s[12:13], s[16:17]
    s_or_b64 s[4:5], s[4:5], s[12:13]
    s_cselect_b32 s20, 0, 1
    s_and_b32 s5, s5, -16
    s_or_b32 s4, s4, s5
    s_cbranch_scc0 L_an_ok
    s_sub_u32 s60, s60, 1
    s_cbranch_scc0 L_an
L_an_ok:
    v_mov_b32 v4, s36
    v_mov_b32 v5, s37
    v_mov_b32 v6, s20
    v_mov_b32 v22, s36
    v_mov_b32 v23, s37
    ds_write_b96 v9, v[4:6] offset:96
    s_mov_b32 s60, 0x40000
L_lds:
    ds_read_b64 v[16:17], v15
    s_sub_u32 s60, s60, 1
    s_waitcnt lgkmcnt(0)
    v_cmp_eq_u32 vcc, 0, v17
    s_cbranch_scc1 L_lds_ok
    s_cbranch_vccnz L_lds
L_lds_ok:
    s_mov_b64 s[38:39], -1
    s_mov_b32 s60, 0x40000
    v_max_f32_dpp v20, v16, v16 row_ror:4 row_mask:0xf bank_mask:0xf
    s_cmp_eq_u32 s20, 1
    s_nop 0
    v_max_f32_dpp v20, v20, v20 row_ror:2 row_mask:0xf bank_mask:0xf
    s_nop 1
    v_max_f32_dpp v20, v20, v20 row_ror:1 row_mask:0xf bank_mask:0xf
    v_sub_f32 v16, v16, v20
    v_exp_f32 v16, v16
    s_nop 0
    v_mul_f32 v21, v17, v16
    ds_write_b32 v14, v16 offset:64
    s_nop 0
    v_add_f32_dpp v21, v21, v21 row_ror:4 row_mask:0xf bank_mask:0xf
    s_nop 1
    v_add_f32_dpp v21, v21, v21 row_ror:2 row_mask:0xf bank_mask:0xf
    s_nop 1
    v_add_f32_dpp v21, v21, v21 row_ror:1 row_mask:0xf bank_mask:0xf
    s_mov_b64 exec, 1
    s_cbranch_scc0 L_ml_far
    buffer_store_dwordx4 v[20:23], v19, s[40:43], 0 offen
L_ml_done:
    s_mov_b64 exec, -1
    s_waitcnt lgkmcnt(0)
    s_barrier
    s_barrier
    buffer_load_dwordx4 v[20:23], v2, s[40:43], 0 offen sc1
    buffer_load_dwordx4 v[24:27], v1, s[40:43], 0 offen sc1
    s_waitcnt vmcnt(1)
    v_cmp_ne_u64 vcc, s[36:37], v[22:23]
    buffer_load_dwordx4 v[28:31], v1, s[40:43], 0 offen sc1
    s_cbranch_vccnz L_ml_retry
L_ml_ok:
    s_nop 1
    v_max_f32_dpp v16, v20, v20 row_ror:4 row_mask:0xf bank_mask:0xf
    s_nop 1
    v_max_f32_dpp v16, v16, v16 row_ror:8 row_mask:0xf bank_mask:0xf
    v_mov_b32 v17, v16
    s_nop 1
    v_permlane32_swap_b32 v16, v17
    s_nop 0
    v_max_f32 v16, v16, v17
    v_max_f32 v16, v16, v10
    v_sub_f32 v14, v20, v16
    v_sub_f32 v10, v10, v16
    v_exp_f32 v14, v14
    v_exp_f32 v10, v10
    v_mul_f32 v21, v14, v21
    buffer_load_dwordx4 v[32:35], v1, s[40:43], 0 offen sc1
    v_mul_f32 v12, v12, v10
    v_add_f32_dpp v21, v21, v21 row_ror:4 row_mask:0xf bank_mask:0xf
    v_mul_f32 v13, v13, v10
    s_nop 0
    v_add_f32_dpp v21, v21, v21 row_ror:8 row_mask:0xf bank_mask:0xf
    v_mov_b32 v18, v21
    s_nop 1
    v_permlane32_swap_b32 v21, v18
    s_nop 0
    v_add_f32 v21, v21, v18
    v_add_f32 v21, v21, v10
    v_rcp_f32 v21, v21
    s_nop 0
    v_mul_f32 v14, v14, v21
    v_mul_f32 v12, v12, v21
    v_mul_f32 v13, v13, v21
L_o0:
    s_waitcnt vmcnt(2)
    v_cmpx_eq_u64 vcc, s[36:37], v[26:27]
    v_pk_fma_f32 v[16:17], v[24:25], v[14:15], v[12:13] op_sel_hi:[1,0,1]
    s_andn2_b64 s[38:39], s[38:39], vcc
    s_cbranch_scc1 L_n0
L_fin:
    s_mov_b64 exec, -1
    v_permlane32_swap_b32 v16, v17
    s_mov_b32 s4, 0x000f000f
    v_add_f32 v16, v16, v17
    s_mov_b32 s5, s4
    s_cmp_lg_u32 s23, 7
    v_add_f32_dpp v16, v16, v16 row_ror:8 row_mask:0xf bank_mask:0xf
    s_nop 1
    v_add_f32_dpp v16, v16, v16 row_ror:4 row_mask:0xf bank_mask:0xf
    s_mov_b64 exec, s[4:5]
    v_cvt_pk_bf16_f32 v16, v16, v16
    buffer_store_short v16, v3, s[48:51], 0 offen
    s_cbranch_scc0 L_epoch
    s_endpgm
L_n0:
    s_mov_b64 exec, s[38:39]
    buffer_load_dwordx4 v[24:27], v1, s[40:43], 0 offen sc1
L_o1:
    s_waitcnt vmcnt(2)
    v_cmpx_eq_u64 vcc, s[36:37], v[30:31]
    v_pk_fma_f32 v[16:17], v[28:29], v[14:15], v[12:13] op_sel_hi:[1,0,1]
    s_andn2_b64 s[38:39], s[38:39], vcc
    s_cbranch_scc1 L_n1
    s_mov_b64 exec, -1
    v_permlane32_swap_b32 v16, v17
    s_mov_b32 s4, 0x000f000f
    v_add_f32 v16, v16, v17
    s_mov_b32 s5, s4
    s_cmp_lg_u32 s23, 7
    v_add_f32_dpp v16, v16, v16 row_ror:8 row_mask:0xf bank_mask:0xf
    s_nop 1
    v_add_f32_dpp v16, v16, v16 row_ror:4 row_mask:0xf bank_mask:0xf
    s_mov_b64 exec, s[4:5]
    v_cvt_pk_bf16_f32 v16, v16, v16
    buffer_store_short v16, v3, s[48:51], 0 offen
    s_cbranch_scc0 L_epoch
    s_endpgm
L_n1:
    s_mov_b64 exec, s[38:39]
    buffer_load_dwordx4 v[28:31], v1, s[40:43], 0 offen sc1
L_o2:
    s_waitcnt vmcnt(2)
    v_cmpx_eq_u64 vcc, s[36:37], v[34:35]
    v_pk_fma_f32 v[16:17], v[32:33], v[14:15], v[12:13] op_sel_hi:[1,0,1]
    s_andn2_b64 s[38:39], s[38:39], vcc
    s_cbranch_scc1 L_n2
    s_mov_b64 exec, -1
    v_permlane32_swap_b32 v16, v17
    s_mov_b32 s4, 0x000f000f
    v_add_f32 v16, v16, v17
    s_mov_b32 s5, s4
    s_cmp_lg_u32 s23, 7
    v_add_f32_dpp v16, v16, v16 row_ror:8 row_mask:0xf bank_mask:0xf
    s_nop 1
    v_add_f32_dpp v16, v16, v16 row_ror:4 row_mask:0xf bank_mask:0xf
    s_mov_b64 exec, s[4:5]
    v_cvt_pk_bf16_f32 v16, v16, v16
    buffer_store_short v16, v3, s[48:51], 0 offen
    s_cbranch_scc0 L_epoch
    s_endpgm
L_n2:
    s_mov_b64 exec, s[38:39]
    buffer_load_dwordx4 v[32:35], v1, s[40:43], 0 offen sc1
    s_sub_u32 s60, s60, 1
    s_cbranch_scc0 L_o0
    s_branch L_fin
L_ml_far:
    buffer_store_dwordx4 v[20:23], v19, s[40:43], 0 offen sc1
    s_branch L_ml_done
L_ml_retry:
    buffer_load_dwordx4 v[20:23], v2, s[40:43], 0 offen sc1
    s_waitcnt vmcnt(0)
    v_cmp_ne_u64 vcc, s[36:37], v[22:23]
    s_sub_u32 s60, s60, 1
    s_cbranch_scc1 L_ml_ok
    s_cbranch_vccnz L_ml_retry
    s_branch L_ml_ok
L_epoch:
    s_mov_b64 exec, 1
    buffer_store_dwordx2 v[4:5], v8, s[40:43], 0 offen
L_end:
    s_endpgm
.section .rodata,"a"
.p2align 6
.amdhsa_kernel standalone__tree_speculative_verify_tree_attention_over_candidate_token_tree__decode_kernel
  .amdhsa_next_free_vgpr 164
  .amdhsa_next_free_sgpr 96
  .amdhsa_accum_offset 164
  .amdhsa_group_segment_fixed_size 0
  .amdhsa_kernarg_size 72
  .amdhsa_user_sgpr_count 2
  .amdhsa_user_sgpr_kernarg_segment_ptr 1
  .amdhsa_system_sgpr_workgroup_id_x 1
.end_amdhsa_kernel
```
